```python
import torch

def _softmax(x, axis=-1):
    return torch.softmax(x, dim=axis)
def _gelu(x):
    return torch.nn.functional.gelu(x, approximate="tanh")
def _silu(x):
    return torch.nn.functional.silu(x)
def _sigmoid(x):
    return torch.sigmoid(x)
def _layernorm(x, axis=-1, eps=1e-5):
    m = x.mean(dim=axis, keepdim=True)
    v = x.var(dim=axis, keepdim=True, unbiased=False)
    return (x - m) / torch.sqrt(v + eps)
def _scatter_add(tgt, idx, src, axis=0):
    return tgt.clone().index_add_(axis, idx, src)
def _segment_sum(src, seg, n):
    out = torch.zeros((n,) + src.shape[1:], dtype=src.dtype)
    return out.index_add_(0, seg, src)
def _pad(x, pw):
    flat = tuple(v for pair in reversed(pw) for v in pair)
    return torch.nn.functional.pad(x, flat)

kernel_name = 'standalone__instancenorm__sampling'

def setup_inputs():

    _w = (lambda a: (lambda t: t.to(torch.bfloat16) if t.is_floating_point() else t)(torch.as_tensor(a)))
    B, C, H, W = 64, 512, 32, 32
    return {
        "x": _w(abs((lambda *s: torch.randn(*s, dtype=torch.bfloat16) * 0.05)(B, C, H, W))),
        "g": _w((lambda *s: torch.randn(*s, dtype=torch.bfloat16) * 0.05)(C) + 1.0),
        "b": _w((lambda *s: torch.randn(*s, dtype=torch.bfloat16) * 0.4)(C)),
    }

def reference(x, g, b):
    mu = x.mean(axis=(-2, -1), keepdims=True)
    var = ((x - mu) ** 2).mean(axis=(-2, -1), keepdims=True)
    xhat = (x - mu) / torch.sqrt(var + 1e-5)
    return xhat * g.reshape(1, -1, 1, 1) + b.reshape(1, -1, 1, 1)
```

```asm
; @launch grid=(256,1,1) block=(512,1,1) lds=84000
.amdgcn_target "amdgcn-amd-amdhsa--gfx950"
.text
.globl standalone__instancenorm__sampling_kernel
.p2align 12
.p2align 8
.type standalone__instancenorm__sampling_kernel,@function
standalone__instancenorm__sampling_kernel:
    s_memrealtime s[38:39]
    s_load_dwordx8 s[4:11], s[0:1], 0
    s_load_dwordx2 s[30:31], s[0:1], 32
    s_cmpk_ge_u32 s2, 0x100
    s_cbranch_scc1 L_done
    v_cmp_gt_u32 vcc, 64, v0
    v_readfirstlane_b32 s16, v0
    s_xor_b32 s22, s2, 1
    s_and_b32 s22, s22, 7
    s_mulk_i32 s22, 0x81
    s_lshl_b32 s22, s22, 8
    s_waitcnt lgkmcnt(4)
    s_bitset1_b32 s22, 22
    s_lshr_b32 s24, s38, 2
    s_and_b32 s24, s24, 0x45f00
    s_xor_b32 s22, s22, s24
    s_lshl_b32 s24, s38, 6
    s_and_b32 s24, s24, 0x3a00000
    s_or_b32 s25, s22, s24
    v_and_b32 v0, 63, v0
    v_lshlrev_b32 v0, 4, v0
    v_and_b32 v1, 0x380, v0
    v_add_u32 v0, v0, v1
    s_mov_b32 s40, 0x3ffffff
    s_cbranch_vccz L_setup
    s_or_b32 s27, s25, 0x80
    s_or_b32 s28, s25, 0x2080
    s_waitcnt lgkmcnt(0)
    s_and_b32 s3, s4, 0x1ff800
    s_sub_u32 s27, s27, s3
    s_sub_u32 s28, s28, s3
    s_load_dword s27, s[4:5], s27
    s_load_dword s28, s[4:5], s28
L_setup:
    s_and_b32 s14, s2, 3
    s_lshr_b32 s15, s2, 3
    s_lshl2_add_u32 s17, s15, s14
    s_lshl_b32 s17, s17, 4
    s_bfe_u32 s18, s16, 0x20006
    s_or_b32 s17, s17, s18
    s_lshr_b32 s13, s2, 2
    s_xor_b32 s18, s18, s13
    s_and_b32 s18, s18, 1
    s_lshl2_add_u32 s17, s18, s17
    s_lshr_b32 s18, s16, 8
    s_xor_b32 s18, s18, s15
    s_lshr_b32 s19, s2, 5
    s_xor_b32 s18, s18, s19
    s_and_b32 s18, s18, 1
    s_lshl3_add_u32 s17, s18, s17
    s_and_b32 s19, s19, 1
    s_lshl_b32 s12, s19, 11
    s_or_b32 s17, s17, s12
    s_lshl_b32 s17, s17, 11
    s_cbranch_vccnz L_based
    s_bfe_u32 s27, s2, 0x30004
    s_lshl_b32 s27, s27, 8
    s_or_b32 s27, s27, s17
    s_waitcnt lgkmcnt(0)
    s_and_b32 s3, s4, 0x1ff800
    s_sub_u32 s27, s27, s3
    s_and_b32 s27, s27, s40
    s_load_dword s27, s[4:5], s27
L_based:
    s_sub_u32 s24, s17, s3
    s_and_b32 s24, s24, s40
    v_add_u32 v1, s24, v0
    s_xor_b32 s19, s17, 0x2000
    s_sub_u32 s19, s19, s3
    s_bfe_u32 s18, s24, 0x8000c
    s_lshl_b32 s18, s18, 2
    s_bfe_u32 s19, s19, 0x8000c
    s_lshl_b32 s19, s19, 2
    s_load_dword s32, s[6:7], s18
    s_load_dword s33, s[8:9], s18
    s_load_dword s36, s[6:7], s19
    s_load_dword s37, s[8:9], s19
    s_cbranch_vccz L_skip
    s_sub_u32 s26, s25, s3
    v_mov_b32 v28, s26
    v_add_u32 v29, 0x2000, v28
    global_load_dword v30, v28, s[4:5] nt
    global_load_dword v31, v29, s[4:5] nt
L_skip:
    s_barrier
    global_load_dwordx4 v[4:7], v1, s[4:5] nt
    global_load_dwordx4 v[8:11], v1, s[4:5] offset:128 nt
    s_bitcmp1_b32 s24, 11
    s_cselect_b32 s23, 0, 16
    s_lshl_b32 s12, s12, 12
    s_sub_u32 s15, 0x400000, s12
    s_bitset1_b32 s12, 22
    s_and_b32 s13, s13, 1
    s_lshl_b32 s14, s14, 2
    v_mov_b32 v48, s14
    v_mov_b32 v3, 0
    v_mov_b32 v36, 0x3a803a80
    v_mov_b32 v37, v36
    v_mov_b64 v[38:39], v[36:37]
    s_mov_b32 s20, 0xffff0000
    s_mov_b32 s21, s20
    s_lshr_b32 s24, s17, 8
    s_xor_b32 s24, s24, s17
    s_lshr_b32 s24, s24, 13
    s_xor_b32 s26, s24, s13
    s_add_u32 s17, s17, s15
    s_mov_b32 s22, 8
    s_cbranch_vccz L_chosen
L_race:
    s_waitcnt vmcnt(3)
    s_lshr_b32 s24, s25, 21
    s_xor_b32 s24, s24, s13
    s_and_b32 s24, s24, 1
    s_add_u32 s25, s24, 1
    s_sub_u32 s24, 2, s24
    s_getreg_b32 s29, hwreg(HW_REG_IB_STS, 0, 4)
    s_cmp_eq_u32 s29, 3
    s_cselect_b32 s29, s25, s24
    v_mov_b32 v33, s29
    ds_write_b32 v3, v33
    s_cmp_ge_u32 s2, 4
    s_cbranch_scc1 L_nopub
    global_store_dword v48, v33, s[30:31] sc0 sc1
L_nopub:
    s_waitcnt lgkmcnt(0)
L_chosen:
    s_barrier
    ds_read_b32 v33, v3
    s_cmp_lt_u32 s2, 4
    s_cselect_b64 vcc, 0, -1
    s_waitcnt lgkmcnt(0)
    v_readfirstlane_b32 s29, v33
    s_xnor_b32 s28, s29, s26
    s_and_b32 s28, s28, 1
    s_lshl_b32 s28, s28, 13
    s_xor_b32 s17, s17, s28
    s_sub_u32 s24, s17, s3
    s_and_b32 s24, s24, s40
    v_add_u32 v2, s24, v0
    global_load_dwordx4 v[40:43], v2, s[4:5] nt
    s_xor_b32 s26, s17, 0x2000
    s_sub_u32 s25, 3, s29
    s_lshl_b64 s[32:33], s[32:33], s23
    s_and_b64 s[32:33], s[32:33], s[20:21]
    s_lshl_b64 s[36:37], s[36:37], s23
    s_and_b64 s[36:37], s[36:37], s[20:21]
    s_cmp_lg_u32 s28, 0
    s_cselect_b64 s[34:35], s[36:37], s[32:33]
    s_cselect_b64 s[36:37], s[32:33], s[36:37]
    s_waitcnt vmcnt(1)
    s_branch L_second0
.p2align 3
L_verify:
    s_load_dword s24, s[30:31], s14
    s_waitcnt lgkmcnt(0)
    s_cmp_lg_u32 s24, 0
    s_cbranch_scc1 L_seen
    global_load_dword v3, v48, s[30:31] sc1
    s_waitcnt vmcnt(0)
    v_readfirstlane_b32 s24, v3
L_seen:
    s_cmp_eq_u32 s24, s25
    s_cbranch_scc1 L_switch
    s_cmp_eq_u32 s24, s29
    s_cselect_b64 vcc, 0, vcc
L_row0:
    s_waitcnt vmcnt(2)
    global_load_dwordx4 v[40:43], v2, s[4:5] nt
L_second0:
    global_load_dwordx4 v[44:47], v2, s[4:5] offset:128 nt
    v_mfma_f32_16x16x32_bf16 v[28:31], v[36:39], v[4:7], 0
    v_mfma_f32_16x16x32_bf16 v[28:31], v[36:39], v[8:11], v[28:31]
    v_lshlrev_b32 v12, 16, v4
    v_and_b32 v13, s20, v4
    v_lshlrev_b32 v14, 16, v5
    v_and_b32 v15, s20, v5
    v_lshlrev_b32 v16, 16, v6
    v_and_b32 v17, s20, v6
    v_lshlrev_b32 v18, 16, v7
    v_and_b32 v19, s20, v7
    v_add_f32_dpp v28, v28, v28 row_ror:8 row_mask:0xf bank_mask:0xf
    v_lshlrev_b32 v20, 16, v8
    v_and_b32 v21, s20, v8
    v_add_f32_dpp v28, v28, v28 row_ror:4 row_mask:0xf bank_mask:0xf
    v_lshlrev_b32 v22, 16, v9
    v_and_b32 v23, s20, v9
    v_add_f32_dpp v28, v28, v28 row_ror:2 row_mask:0xf bank_mask:0xf
    v_lshlrev_b32 v24, 16, v10
    v_and_b32 v25, s20, v10
    v_add_f32_dpp v28, v28, v28 row_ror:1 row_mask:0xf bank_mask:0xf
    v_lshlrev_b32 v26, 16, v11
    v_and_b32 v27, s20, v11
    v_cvt_pk_bf16_f32 v28, 0, v28
    v_pk_add_f32 v[12:13], v[12:13], v[28:29] op_sel_hi:[1,0] neg_lo:[0,1] neg_hi:[0,1]
    v_pk_add_f32 v[14:15], v[14:15], v[28:29] op_sel_hi:[1,0] neg_lo:[0,1] neg_hi:[0,1]
    v_pk_add_f32 v[16:17], v[16:17], v[28:29] op_sel_hi:[1,0] neg_lo:[0,1] neg_hi:[0,1]
    v_pk_add_f32 v[18:19], v[18:19], v[28:29] op_sel_hi:[1,0] neg_lo:[0,1] neg_hi:[0,1]
    v_pk_add_f32 v[20:21], v[20:21], v[28:29] op_sel_hi:[1,0] neg_lo:[0,1] neg_hi:[0,1]
    v_pk_add_f32 v[22:23], v[22:23], v[28:29] op_sel_hi:[1,0] neg_lo:[0,1] neg_hi:[0,1]
    v_pk_add_f32 v[24:25], v[24:25], v[28:29] op_sel_hi:[1,0] neg_lo:[0,1] neg_hi:[0,1]
    v_pk_add_f32 v[26:27], v[26:27], v[28:29] op_sel_hi:[1,0] neg_lo:[0,1] neg_hi:[0,1]
    v_pk_mul_f32 v[30:31], v[12:13], v[12:13]
    v_pk_mul_f32 v[32:33], v[14:15], v[14:15]
    v_pk_fma_f32 v[30:31], v[16:17], v[16:17], v[30:31]
    v_pk_fma_f32 v[32:33], v[18:19], v[18:19], v[32:33]
    v_pk_fma_f32 v[30:31], v[20:21], v[20:21], v[30:31]
    v_pk_fma_f32 v[32:33], v[22:23], v[22:23], v[32:33]
    v_pk_fma_f32 v[30:31], v[24:25], v[24:25], v[30:31]
    v_pk_fma_f32 v[32:33], v[26:27], v[26:27], v[32:33]
    v_pk_add_f32 v[30:31], v[30:31], v[32:33]
    v_add_f32 v30, v30, v31
    s_add_u32 s17, s17, s12
    v_mov_b32 v32, 0x3727c5ac
    v_add_f32_dpp v30, v30, v30 row_ror:8 row_mask:0xf bank_mask:0xf
    s_sub_u32 s24, s17, s3
    s_and_b32 s24, s24, s40
    v_add_f32_dpp v30, v30, v30 row_ror:4 row_mask:0xf bank_mask:0xf
    s_nop 1
    v_add_f32_dpp v30, v30, v30 row_ror:2 row_mask:0xf bank_mask:0xf
    s_nop 1
    v_add_f32_dpp v30, v30, v30 row_ror:1 row_mask:0xf bank_mask:0xf
    s_nop 1
    v_add_f32_dpp v30, v30, v30 row_bcast:15 row_mask:0xa bank_mask:0xf
    s_nop 1
    v_add_f32_dpp v30, v30, v30 row_bcast:31 row_mask:0xc bank_mask:0xf
    v_fmac_f32 v32, 0x3a800000, v30
    v_rsq_f32 v32, v32
    s_sub_u32 s22, s22, 1
    v_mul_f32 v32, s32, v32
    s_nop 0
    v_readlane_b32 s32, v32, 63
    s_cmp_eq_u32 s22, 0
    s_nop 0
    v_pk_fma_f32 v[12:13], v[12:13], s[32:33], s[32:33] op_sel:[0,0,1] op_sel_hi:[1,0,1]
    v_pk_fma_f32 v[14:15], v[14:15], s[32:33], s[32:33] op_sel:[0,0,1] op_sel_hi:[1,0,1]
    v_pk_fma_f32 v[16:17], v[16:17], s[32:33], s[32:33] op_sel:[0,0,1] op_sel_hi:[1,0,1]
    v_pk_fma_f32 v[18:19], v[18:19], s[32:33], s[32:33] op_sel:[0,0,1] op_sel_hi:[1,0,1]
    v_cvt_pk_bf16_f32 v4, v12, v13
    v_cvt_pk_bf16_f32 v5, v14, v15
    v_cvt_pk_bf16_f32 v6, v16, v17
    v_cvt_pk_bf16_f32 v7, v18, v19
    global_store_dwordx4 v1, v[4:7], s[10:11] sc0 sc1
    v_pk_fma_f32 v[20:21], v[20:21], s[32:33], s[32:33] op_sel:[0,0,1] op_sel_hi:[1,0,1]
    v_pk_fma_f32 v[22:23], v[22:23], s[32:33], s[32:33] op_sel:[0,0,1] op_sel_hi:[1,0,1]
    v_pk_fma_f32 v[24:25], v[24:25], s[32:33], s[32:33] op_sel:[0,0,1] op_sel_hi:[1,0,1]
    v_pk_fma_f32 v[26:27], v[26:27], s[32:33], s[32:33] op_sel:[0,0,1] op_sel_hi:[1,0,1]
    v_cvt_pk_bf16_f32 v8, v20, v21
    v_cvt_pk_bf16_f32 v9, v22, v23
    v_cvt_pk_bf16_f32 v10, v24, v25
    v_cvt_pk_bf16_f32 v11, v26, v27
    global_store_dwordx4 v1, v[8:11], s[10:11] offset:128 sc0 sc1
    v_add_u32 v1, s24, v0
    s_mov_b64 s[32:33], s[34:35]
L_row1:
    s_waitcnt vmcnt(2)
    s_cbranch_scc1 L_noload1
    global_load_dwordx4 v[4:7], v1, s[4:5] nt
    global_load_dwordx4 v[8:11], v1, s[4:5] offset:128 nt
L_noload1:
    v_mfma_f32_16x16x32_bf16 v[28:31], v[36:39], v[40:43], 0
    v_mfma_f32_16x16x32_bf16 v[28:31], v[36:39], v[44:47], v[28:31]
    v_lshlrev_b32 v12, 16, v40
    v_and_b32 v13, s20, v40
    v_lshlrev_b32 v14, 16, v41
    v_and_b32 v15, s20, v41
    v_lshlrev_b32 v16, 16, v42
    v_and_b32 v17, s20, v42
    v_lshlrev_b32 v18, 16, v43
    v_and_b32 v19, s20, v43
    v_add_f32_dpp v28, v28, v28 row_ror:8 row_mask:0xf bank_mask:0xf
    v_lshlrev_b32 v20, 16, v44
    v_and_b32 v21, s20, v44
    v_add_f32_dpp v28, v28, v28 row_ror:4 row_mask:0xf bank_mask:0xf
    v_lshlrev_b32 v22, 16, v45
    v_and_b32 v23, s20, v45
    v_add_f32_dpp v28, v28, v28 row_ror:2 row_mask:0xf bank_mask:0xf
    v_lshlrev_b32 v24, 16, v46
    v_and_b32 v25, s20, v46
    v_add_f32_dpp v28, v28, v28 row_ror:1 row_mask:0xf bank_mask:0xf
    v_lshlrev_b32 v26, 16, v47
    v_and_b32 v27, s20, v47
    v_cvt_pk_bf16_f32 v28, 0, v28
    v_pk_add_f32 v[12:13], v[12:13], v[28:29] op_sel_hi:[1,0] neg_lo:[0,1] neg_hi:[0,1]
    v_pk_add_f32 v[14:15], v[14:15], v[28:29] op_sel_hi:[1,0] neg_lo:[0,1] neg_hi:[0,1]
    v_pk_add_f32 v[16:17], v[16:17], v[28:29] op_sel_hi:[1,0] neg_lo:[0,1] neg_hi:[0,1]
    v_pk_add_f32 v[18:19], v[18:19], v[28:29] op_sel_hi:[1,0] neg_lo:[0,1] neg_hi:[0,1]
    v_pk_add_f32 v[20:21], v[20:21], v[28:29] op_sel_hi:[1,0] neg_lo:[0,1] neg_hi:[0,1]
    v_pk_add_f32 v[22:23], v[22:23], v[28:29] op_sel_hi:[1,0] neg_lo:[0,1] neg_hi:[0,1]
    v_pk_add_f32 v[24:25], v[24:25], v[28:29] op_sel_hi:[1,0] neg_lo:[0,1] neg_hi:[0,1]
    v_pk_add_f32 v[26:27], v[26:27], v[28:29] op_sel_hi:[1,0] neg_lo:[0,1] neg_hi:[0,1]
    v_pk_mul_f32 v[30:31], v[12:13], v[12:13]
    v_pk_mul_f32 v[32:33], v[14:15], v[14:15]
    v_pk_fma_f32 v[30:31], v[16:17], v[16:17], v[30:31]
    v_pk_fma_f32 v[32:33], v[18:19], v[18:19], v[32:33]
    v_pk_fma_f32 v[30:31], v[20:21], v[20:21], v[30:31]
    v_pk_fma_f32 v[32:33], v[22:23], v[22:23], v[32:33]
    v_pk_fma_f32 v[30:31], v[24:25], v[24:25], v[30:31]
    v_pk_fma_f32 v[32:33], v[26:27], v[26:27], v[32:33]
    v_pk_add_f32 v[30:31], v[30:31], v[32:33]
    v_add_f32 v30, v30, v31
    s_add_u32 s17, s17, s15
    v_mov_b32 v32, 0x3727c5ac
    v_add_f32_dpp v30, v30, v30 row_ror:8 row_mask:0xf bank_mask:0xf
    s_sub_u32 s24, s17, s3
    s_and_b32 s24, s24, s40
    v_add_f32_dpp v30, v30, v30 row_ror:4 row_mask:0xf bank_mask:0xf
    s_nop 1
    v_add_f32_dpp v30, v30, v30 row_ror:2 row_mask:0xf bank_mask:0xf
    s_nop 1
    v_add_f32_dpp v30, v30, v30 row_ror:1 row_mask:0xf bank_mask:0xf
    s_nop 1
    v_add_f32_dpp v30, v30, v30 row_bcast:15 row_mask:0xa bank_mask:0xf
    s_nop 1
    v_add_f32_dpp v30, v30, v30 row_bcast:31 row_mask:0xc bank_mask:0xf
    v_fmac_f32 v32, 0x3a800000, v30
    v_rsq_f32 v32, v32
    s_nop 0
    v_mul_f32 v32, s32, v32
    s_nop 0
    v_readlane_b32 s32, v32, 63
    s_cmp_eq_u32 s22, 0
    s_nop 0
    v_pk_fma_f32 v[12:13], v[12:13], s[32:33], s[32:33] op_sel:[0,0,1] op_sel_hi:[1,0,1]
    v_pk_fma_f32 v[14:15], v[14:15], s[32:33], s[32:33] op_sel:[0,0,1] op_sel_hi:[1,0,1]
    v_pk_fma_f32 v[16:17], v[16:17], s[32:33], s[32:33] op_sel:[0,0,1] op_sel_hi:[1,0,1]
    v_pk_fma_f32 v[18:19], v[18:19], s[32:33], s[32:33] op_sel:[0,0,1] op_sel_hi:[1,0,1]
    v_cvt_pk_bf16_f32 v40, v12, v13
    v_cvt_pk_bf16_f32 v41, v14, v15
    v_cvt_pk_bf16_f32 v42, v16, v17
    v_cvt_pk_bf16_f32 v43, v18, v19
    global_store_dwordx4 v2, v[40:43], s[10:11] sc0 sc1
    v_pk_fma_f32 v[20:21], v[20:21], s[32:33], s[32:33] op_sel:[0,0,1] op_sel_hi:[1,0,1]
    v_pk_fma_f32 v[22:23], v[22:23], s[32:33], s[32:33] op_sel:[0,0,1] op_sel_hi:[1,0,1]
    v_pk_fma_f32 v[24:25], v[24:25], s[32:33], s[32:33] op_sel:[0,0,1] op_sel_hi:[1,0,1]
    v_pk_fma_f32 v[26:27], v[26:27], s[32:33], s[32:33] op_sel:[0,0,1] op_sel_hi:[1,0,1]
    v_cvt_pk_bf16_f32 v44, v20, v21
    v_cvt_pk_bf16_f32 v45, v22, v23
    v_cvt_pk_bf16_f32 v46, v24, v25
    v_cvt_pk_bf16_f32 v47, v26, v27
    global_store_dwordx4 v2, v[44:47], s[10:11] offset:128 sc0 sc1
    v_add_u32 v2, s24, v0
    s_mov_b64 s[32:33], s[34:35]
    s_cbranch_scc1 L_out
    s_cbranch_vccz L_row0
    s_branch L_verify
L_out:
    s_cbranch_vccnz L_switch
L_done:
    s_endpgm
L_switch:
    s_mov_b32 s17, s26
    s_sub_u32 s24, s17, s3
    s_and_b32 s24, s24, s40
    v_add_u32 v2, s24, v0
    global_load_dwordx4 v[40:43], v2, s[4:5] nt
    global_load_dwordx4 v[44:47], v2, s[4:5] offset:128 nt
    s_add_u32 s17, s17, s12
    s_sub_u32 s24, s17, s3
    s_and_b32 s24, s24, s40
    v_add_u32 v1, s24, v0
    s_mov_b64 s[32:33], s[36:37]
    s_mov_b64 s[34:35], s[36:37]
    s_mov_b64 vcc, 0
    s_mov_b32 s22, 7
    s_cmp_eq_u32 s22, 0
    s_waitcnt vmcnt(0)
    s_branch L_row1
.section .rodata,"a"
.p2align 6
.amdhsa_kernel standalone__instancenorm__sampling_kernel
  .amdhsa_next_free_vgpr 49
  .amdhsa_next_free_sgpr 41
  .amdhsa_accum_offset 52
  .amdhsa_group_segment_fixed_size 0
  .amdhsa_kernarg_size 48
  .amdhsa_user_sgpr_count 2
  .amdhsa_user_sgpr_kernarg_segment_ptr 1
  .amdhsa_system_sgpr_workgroup_id_x 1
  .amdhsa_float_denorm_mode_32 3
.end_amdhsa_kernel
```
